```python
import torch

def _softmax(x, axis=-1):
    return torch.softmax(x, dim=axis)

def _gelu(x):
    return torch.nn.functional.gelu(x, approximate='tanh')

def _silu(x):
    return torch.nn.functional.silu(x)

def _sigmoid(x):
    return torch.sigmoid(x)

def _layernorm(x, axis=-1, eps=1e-05):
    m = x.mean(dim=axis, keepdim=True)
    v = x.var(dim=axis, keepdim=True, unbiased=False)
    return (x - m) / torch.sqrt(v + eps)

def _scatter_add(tgt, idx, src, axis=0):
    return tgt.clone().index_add_(axis, idx, src)

def _segment_sum(src, seg, n):
    out = torch.zeros((n,) + src.shape[1:], dtype=src.dtype)
    return out.index_add_(0, seg, src)

def _pad(x, pw):
    flat = tuple((v for pair in reversed(pw) for v in pair))
    return torch.nn.functional.pad(x, flat)
kernel_name = 'standalone__tree_speculative_verify_tree_attention_over_candidate_token_tree__sampling'

def setup_inputs():

    _w = lambda a: (lambda t: t.to(torch.bfloat16) if t.is_floating_point() else t)(torch.as_tensor(a))
    B, Hq, Hkv, T, C, D = (32, 32, 4, 16, 2048, 128)
    tree_mask = torch.zeros((B, T, T), dtype=float)
    for b in range(B):
        parent = torch.zeros(T, dtype=torch.int64)
        for i in range(1, T):
            parent[i] = int(torch.randint(0, i, (1,)).item())
        for i in range(T):
            j = i
            tree_mask[b, i, j] = 1.0
            while j > 0:
                j = parent[j]
                tree_mask[b, i, j] = 1.0
    return {'q': _w((lambda *s: torch.randn(*s, dtype=torch.bfloat16) * 0.8)(B, Hq, T, D)), 'k_cache': _w((lambda *s: torch.randn(*s, dtype=torch.bfloat16) * 0.8)(B, Hkv, C, D)), 'v_cache': _w((lambda *s: torch.randn(*s, dtype=torch.bfloat16) * 0.05)(B, Hkv, C, D)), 'k_tree': _w((lambda *s: torch.randn(*s, dtype=torch.bfloat16) * 0.8)(B, Hkv, T, D)), 'v_tree': _w((lambda *s: torch.randn(*s, dtype=torch.bfloat16) * 0.05)(B, Hkv, T, D)), 'tree_mask': _w(tree_mask)}

def reference(q, k_cache, v_cache, k_tree, v_tree, tree_mask):
    B, Hq, T, D = q.shape
    Hkv, C = (k_cache.shape[1], k_cache.shape[2])
    rep = Hq // Hkv
    kc = (lambda x, n, axis: torch.repeat_interleave(x, n, dim=axis))(k_cache, rep, axis=1)
    vc = (lambda x, n, axis: torch.repeat_interleave(x, n, dim=axis))(v_cache, rep, axis=1)
    kt = (lambda x, n, axis: torch.repeat_interleave(x, n, dim=axis))(k_tree, rep, axis=1)
    vt = (lambda x, n, axis: torch.repeat_interleave(x, n, dim=axis))(v_tree, rep, axis=1)
    k = torch.concatenate([kc, kt], axis=2)
    v = torch.concatenate([vc, vt], axis=2)
    scale = D ** (-0.5)
    scores = torch.einsum('bhqd,bhkd->bhqk', q, k) * scale
    ctx_mask = torch.ones((B, 1, T, C), dtype=scores.dtype)
    tm = tree_mask[:, None, :, :].clone()
    full_mask = torch.concatenate([ctx_mask, tm], axis=-1)
    scores = scores + (1.0 - full_mask) * -1000000000.0
    p = _softmax(scores, axis=-1)
    return torch.einsum('bhqk,bhkd->bhqd', p, v)
```

```asm
; @launch grid=(256,1,1) block=(320,1,1) lds=143616
.amdgcn_target "amdgcn-amd-amdhsa--gfx950"
.text
.globl standalone__tree_speculative_verify_tree_attention_over_candidate_token_tree__sampling_kernel
.p2align 8
.type standalone__tree_speculative_verify_tree_attention_over_candidate_token_tree__sampling_kernel,@function
standalone__tree_speculative_verify_tree_attention_over_candidate_token_tree__sampling_kernel:
    s_cmp_ge_u32 s2, 256
    s_cbranch_scc1 L_end
    s_load_dwordx8 s[4:11], s[0:1], 0
    s_load_dwordx4 s[24:27], s[0:1], 32
    s_load_dwordx2 s[20:21], s[0:1], 48
    v_lshrrev_b32 v1, 6, v0
    s_and_b32 s40, s2, 7
    s_lshr_b32 s41, s2, 4
    v_readfirstlane_b32 s3, v1
    s_lshl_b32 s40, s40, 4
    s_add_u32 s40, s40, s41
    s_bfe_u32 s41, s2, 0x10003
    v_and_b32 v0, 63, v0
    v_lshrrev_b32 v1, 4, v0
    v_and_b32 v2, 2, v1
    v_xor_b32 v2, v0, v2
    v_lshlrev_b32 v2, 4, v2
    v_and_b32 v3, 1, v1
    v_mul_u32_u24 v3, 32512, v3
    v_add_u32 v7, v2, v3
    v_add_u32 v4, 4096, v7
    v_add_u32 v5, 4032, v7
    v_add_u32 v6, 2176, v7
    v_add_u32 v7, 2112, v7
    s_lshl_b32 s33, s40, 12
    s_lshl_b32 s28, s40, 19
    s_sub_u32 s28, s28, 4096
    s_subb_u32 s39, 0, 0
    s_mov_b32 s14, 528384
    s_mov_b32 s15, 0x20000
    s_mov_b32 s19, 0x20000
    s_movk_i32 s22, 0x1000
    s_mov_b32 s23, 0x20000
    s_sub_u32 s3, s3, 1
    s_cbranch_scc1 L_loader
    s_lshl_b32 s32, s40, 1
    s_add_u32 s32, s32, s41
    s_lshl_b32 s32, s32, 2
    s_add_u32 s32, s32, s3
    s_lshl_b32 s32, s32, 12
    s_mul_i32 s29, s3, 4352
    s_add_u32 s29, s29, 126208
    s_mov_b32 m0, s29
    s_xor_b32 s30, s3, s41
    s_mul_i32 s36, s30, 2048
    s_mul_i32 s30, s30, 4352
    s_movk_i32 s18, 0x1000
    s_mul_i32 s38, s3, 1088
    s_lshl_b32 s37, s3, 8
    v_and_b32 v232, 3, v0
    v_bfe_u32 v233, v0, 2, 2
    v_lshl_add_u32 v234, v232, 2, v233
    v_lshlrev_b32 v3, 5, v234
    v_lshl_add_u32 v3, v1, 3, v3
    v_add_u32 v3, 91392, v3
    s_setprio 3
    s_waitcnt lgkmcnt(0)
    s_add_u32 s16, s4, s32
    s_addc_u32 s17, s5, 0
    buffer_load_dwordx4 v2, s[16:19], 0 offen offset:0 nt lds
    s_add_u32 m0, m0, 64
    v_mul_u32_u24 v235, 768, v1
    buffer_load_dwordx4 v2, s[16:19], 0 offen offset:1024 nt lds
    s_add_u32 m0, m0, 64
    v_add_u32 v235, v2, v235
    buffer_load_dwordx4 v2, s[16:19], 0 offen offset:2048 nt lds
    s_add_u32 m0, m0, 64
    s_nop 0
    buffer_load_dwordx4 v2, s[16:19], 0 offen offset:3072 nt lds
    s_setprio 0
    s_add_u32 m0, s30, 104448
    s_add_u32 s12, s6, s28
    s_addc_u32 s13, s7, s39
    buffer_load_dwordx4 v4, s[12:15], s36 offen offset:0 nt lds
    buffer_load_dwordx4 v5, s[12:15], s36 offen offset:1088 nt lds
    buffer_load_dwordx4 v6, s[12:15], s36 offen offset:2176 nt lds
    buffer_load_dwordx4 v7, s[12:15], s36 offen offset:3264 nt lds
    s_add_u32 m0, s38, 121856
    s_add_u32 s16, s10, s33
    s_addc_u32 s17, s11, 0
    buffer_load_dwordx4 v235, s[16:19], s37 offen nt lds
    s_barrier
    s_add_u32 s20, s20, s32
    s_addc_u32 s21, s21, 0
    s_xor_b32 s35, s3, 1
    s_and_b32 s38, s3, 1
    s_mul_i32 s38, s38, 8704
    v_mul_u32_u24 v235, 1088, v232
    v_lshl_add_u32 v235, v233, 8, v235
    v_and_b32 v236, 2, v233
    v_xor_b32 v236, v1, v236
    v_lshl_add_u32 v224, v236, 4, v235
    v_mul_u32_u24 v235, 1088, v233
    v_lshl_add_u32 v235, v1, 8, v235
    v_lshl_add_u32 v235, v232, 3, v235
    v_add_u32 v235, 17408, v235
    v_and_b32 v236, 1, v1
    v_lshl_add_u32 v225, v236, 5, v235
    v_xor_b32 v236, 1, v236
    v_lshl_add_u32 v226, v236, 5, v235
    s_mul_i32 s34, s35, 4352
    s_add_u32 s34, s34, 126208
    v_add_u32 v237, s29, v224
    v_lshl_add_u32 v2, v0, 4, s29
    v_lshl_add_u32 v238, v0, 4, s34
    v_add_u32 v230, 121856, v224
    s_mov_b32 s31, 69632
    v_add_u32 v228, s31, v225
    v_add_u32 v229, s31, v226
    v_add_u32 v224, s38, v224
    v_add_u32 v225, s38, v225
    v_add_u32 v226, s38, v226
    v_add_u32 v227, s31, v224
    v_add_u32 v231, 104448, v224
    s_mul_i32 s34, s3, 4352
    s_add_u32 s34, s34, 104448
    v_mul_u32_u24 v239, 272, v234
    v_lshl_add_u32 v239, v1, 3, v239
    v_add_u32 v239, s34, v239
    v_lshlrev_b32 v241, 4, v0
    v_lshrrev_b32 v235, 3, v0
    v_mul_u32_u24 v240, 144, v235
    v_add3_u32 v240, v240, v241, s34
    s_mul_i32 s34, s3, 8704
    s_mul_i32 s35, s35, 8704
    s_add_u32 s34, s34, 34816
    s_add_u32 s35, s35, 34816
    v_add_u32 v242, s34, v241
    v_add_u32 v243, s35, v241
    v_lshl_add_u32 v244, v0, 3, s34
    v_lshl_add_u32 v245, v0, 3, s35
    v_lshl_add_u32 v241, v235, 7, v241
    v_cmp_eq_u32 vcc, 0, v232
    v_mov_b32 v236, 0x3f803f80
    s_mov_b32 s44, 0x3e0293ee
    s_mov_b32 s45, 0x3e0293ee
    s_mov_b32 s46, 0x4eabfb8f
    s_mov_b32 s47, 0x41800000
    s_mov_b32 s48, 0xffff0000
    s_mov_b32 s30, 0
    v_cndmask_b32 v220, 0, v236, vcc
    v_cndmask_b32 v221, 0, v236, vcc
    v_cndmask_b32 v222, 0, v236, vcc
    v_cndmask_b32 v223, 0, v236, vcc
    v_mov_b32 v172, 0
    v_mov_b32 v173, 0
    v_mov_b32 v174, 0
    v_mov_b32 v175, 0
    v_mov_b32 v176, 0
    v_mov_b32 v177, 0
    v_mov_b32 v178, 0
    v_mov_b32 v179, 0
    v_mov_b32 v180, 0
    v_mov_b32 v181, 0
    v_mov_b32 v182, 0
    v_mov_b32 v183, 0
    v_mov_b32 v184, 0
    v_mov_b32 v185, 0
    v_mov_b32 v186, 0
    v_mov_b32 v187, 0
    v_mov_b32 v188, 0
    v_mov_b32 v189, 0
    v_mov_b32 v190, 0
    v_mov_b32 v191, 0
    v_mov_b32 v192, 0
    v_mov_b32 v193, 0
    v_mov_b32 v194, 0
    v_mov_b32 v195, 0
    v_mov_b32 v196, 0
    v_mov_b32 v197, 0
    v_mov_b32 v198, 0
    v_mov_b32 v199, 0
    v_mov_b32 v200, 0
    v_mov_b32 v201, 0
    v_mov_b32 v202, 0
    v_mov_b32 v203, 0
    v_mov_b32 v216, 0
    v_mov_b32 v217, 0
    v_mov_b32 v218, 0
    v_mov_b32 v219, 0
    s_waitcnt vmcnt(5)
    ds_read_b128 v[4:7], v237 offset:0
    ds_read_b128 v[8:11], v237 offset:64
    ds_read_b128 v[12:15], v237 offset:128
    ds_read_b128 v[16:19], v237 offset:192
    s_waitcnt lgkmcnt(3)
    v_lshlrev_b32 v68, 16, v4
    v_and_b32 v69, s48, v4
    v_lshlrev_b32 v70, 16, v5
    v_and_b32 v71, s48, v5
    v_lshlrev_b32 v72, 16, v6
    v_and_b32 v73, s48, v6
    v_lshlrev_b32 v74, 16, v7
    v_and_b32 v75, s48, v7
    v_mul_f32 v68, s44, v68
    v_mul_f32 v69, s44, v69
    v_mul_f32 v70, s44, v70
    v_mul_f32 v71, s44, v71
    v_mul_f32 v72, s44, v72
    v_mul_f32 v73, s44, v73
    v_mul_f32 v74, s44, v74
    v_mul_f32 v75, s44, v75
    v_cvt_pk_bf16_f32 v4, v68, v69
    v_cvt_pk_bf16_f32 v5, v70, v71
    v_cvt_pk_bf16_f32 v6, v72, v73
    v_cvt_pk_bf16_f32 v7, v74, v75
    s_waitcnt lgkmcnt(2)
    v_lshlrev_b32 v76, 16, v8
    v_and_b32 v77, s48, v8
    v_lshlrev_b32 v78, 16, v9
    v_and_b32 v79, s48, v9
    v_lshlrev_b32 v80, 16, v10
    v_and_b32 v81, s48, v10
    v_lshlrev_b32 v82, 16, v11
    v_and_b32 v83, s48, v11
    v_mul_f32 v76, s44, v76
    v_mul_f32 v77, s44, v77
    v_mul_f32 v78, s44, v78
    v_mul_f32 v79, s44, v79
    v_mul_f32 v80, s44, v80
    v_mul_f32 v81, s44, v81
    v_mul_f32 v82, s44, v82
    v_mul_f32 v83, s44, v83
    v_cvt_pk_bf16_f32 v8, v76, v77
    v_cvt_pk_bf16_f32 v9, v78, v79
    v_cvt_pk_bf16_f32 v10, v80, v81
    v_cvt_pk_bf16_f32 v11, v82, v83
    s_waitcnt lgkmcnt(0)
    v_lshlrev_b32 v68, 16, v12
    v_and_b32 v69, s48, v12
    v_lshlrev_b32 v70, 16, v13
    v_and_b32 v71, s48, v13
    v_lshlrev_b32 v72, 16, v14
    v_and_b32 v73, s48, v14
    v_lshlrev_b32 v74, 16, v15
    v_and_b32 v75, s48, v15
    v_mul_f32 v68, s44, v68
    v_mul_f32 v69, s44, v69
    v_mul_f32 v70, s44, v70
    v_mul_f32 v71, s44, v71
    v_mul_f32 v72, s44, v72
    v_mul_f32 v73, s44, v73
    v_mul_f32 v74, s44, v74
    v_mul_f32 v75, s44, v75
    v_cvt_pk_bf16_f32 v12, v68, v69
    v_cvt_pk_bf16_f32 v13, v70, v71
    v_cvt_pk_bf16_f32 v14, v72, v73
    v_cvt_pk_bf16_f32 v15, v74, v75
    ds_write_b128 v2, v[4:7] offset:0
    ds_write_b128 v2, v[8:11] offset:1024
    ds_write_b128 v2, v[12:15] offset:2048
    v_lshlrev_b32 v76, 16, v16
    v_and_b32 v77, s48, v16
    v_lshlrev_b32 v78, 16, v17
    v_and_b32 v79, s48, v17
    v_lshlrev_b32 v80, 16, v18
    v_and_b32 v81, s48, v18
    v_lshlrev_b32 v82, 16, v19
    v_and_b32 v83, s48, v19
    v_mul_f32 v76, s44, v76
    v_mul_f32 v77, s44, v77
    v_mul_f32 v78, s44, v78
    v_mul_f32 v79, s44, v79
    v_mul_f32 v80, s44, v80
    v_mul_f32 v81, s44, v81
    v_mul_f32 v82, s44, v82
    v_mul_f32 v83, s44, v83
    v_cvt_pk_bf16_f32 v16, v76, v77
    v_cvt_pk_bf16_f32 v17, v78, v79
    v_cvt_pk_bf16_f32 v18, v80, v81
    v_cvt_pk_bf16_f32 v19, v82, v83
    ds_write_b128 v2, v[16:19] offset:3072
    s_waitcnt vmcnt(0) lgkmcnt(0)
    s_barrier
    ds_read_b128 v[36:39], v231 offset:0
    ds_read_b128 v[40:43], v231 offset:4352
    ds_read_b128 v[20:23], v238 offset:0
    ds_read_b128 v[44:47], v231 offset:64
    ds_read_b128 v[48:51], v231 offset:4416
    ds_read_b128 v[24:27], v238 offset:1024
    ds_read_b128 v[52:55], v231 offset:128
    ds_read_b128 v[56:59], v231 offset:4480
    ds_read_b128 v[28:31], v238 offset:2048
    ds_read_b128 v[60:63], v231 offset:192
    ds_read_b128 v[64:67], v231 offset:4544
    ds_read_b128 v[32:35], v238 offset:3072
    s_waitcnt lgkmcnt(11)
    v_mfma_f32_16x16x32_bf16 v[100:103], v[36:39], v[4:7], 0
    s_waitcnt lgkmcnt(9)
    v_mfma_f32_16x16x32_bf16 v[108:111], v[36:39], v[20:23], 0
    ds_read_b128 v[140:143], v230 offset:0
    v_mfma_f32_16x16x32_bf16 v[104:107], v[40:43], v[4:7], 0
    v_mfma_f32_16x16x32_bf16 v[112:115], v[40:43], v[20:23], 0
    ds_read_b128 v[144:147], v230 offset:64
    s_waitcnt lgkmcnt(6)
    v_mfma_f32_16x16x32_bf16 v[100:103], v[44:47], v[8:11], v[100:103]
    v_mfma_f32_16x16x32_bf16 v[108:111], v[44:47], v[24:27], v[108:111]
    ds_read_b128 v[148:151], v230 offset:128
    v_mfma_f32_16x16x32_bf16 v[104:107], v[48:51], v[8:11], v[104:107]
    v_mfma_f32_16x16x32_bf16 v[112:115], v[48:51], v[24:27], v[112:115]
    ds_read_b128 v[152:155], v230 offset:192
    v_mfma_f32_16x16x32_bf16 v[100:103], v[52:55], v[12:15], v[100:103]
    s_waitcnt lgkmcnt(4)
    v_mfma_f32_16x16x32_bf16 v[108:111], v[52:55], v[28:31], v[108:111]
    v_mfma_f32_16x16x32_bf16 v[104:107], v[56:59], v[12:15], v[104:107]
    v_mfma_f32_16x16x32_bf16 v[112:115], v[56:59], v[28:31], v[112:115]
    v_mfma_f32_16x16x32_bf16 v[100:103], v[60:63], v[16:19], v[100:103]
    v_mfma_f32_16x16x32_bf16 v[108:111], v[60:63], v[32:35], v[108:111]
    v_mfma_f32_16x16x32_bf16 v[104:107], v[64:67], v[16:19], v[104:107]
    v_mfma_f32_16x16x32_bf16 v[112:115], v[64:67], v[32:35], v[112:115]
    s_waitcnt lgkmcnt(1)
    v_mfma_f32_16x16x32_bf16 v[116:119], v[140:143], v[4:7], 0
    v_mfma_f32_16x16x32_bf16 v[116:119], v[144:147], v[8:11], v[116:119]
    v_mfma_f32_16x16x32_bf16 v[116:119], v[148:151], v[12:15], v[116:119]
    s_waitcnt lgkmcnt(0)
    v_mfma_f32_16x16x32_bf16 v[116:119], v[152:155], v[16:19], v[116:119]
    s_barrier
    ds_read_b64 v[204:205], v3
    ds_read_b64_tr_b16 v[68:69], v228 offset:0
    ds_read_b64_tr_b16 v[72:73], v229 offset:0
    ds_read_b64_tr_b16 v[76:77], v228 offset:64
    ds_read_b64_tr_b16 v[80:81], v229 offset:64
    ds_read_b64_tr_b16 v[84:85], v228 offset:128
    ds_read_b64_tr_b16 v[88:89], v229 offset:128
    ds_read_b64_tr_b16 v[92:93], v228 offset:192
    ds_read_b64_tr_b16 v[96:97], v229 offset:192
    v_max3_f32 v231, v108, v109, v110
    v_max3_f32 v231, v231, v111, v112
    v_max3_f32 v231, v231, v113, v114
    v_max_f32 v231, v231, v115
    s_waitcnt lgkmcnt(8)
    v_lshlrev_b32 v208, 16, v204
    v_and_b32 v209, s48, v204
    v_lshlrev_b32 v210, 16, v205
    v_and_b32 v211, s48, v205
    v_fma_f32 v208, v208, s46, -s46
    v_fma_f32 v209, v209, s46, -s46
    v_fma_f32 v210, v210, s46, -s46
    v_fma_f32 v211, v211, s46, -s46
    v_add_f32 v116, v116, v208
    v_add_f32 v117, v117, v209
    v_add_f32 v118, v118, v210
    v_add_f32 v119, v119, v211
    v_max3_f32 v230, v100, v101, v102
    v_max3_f32 v230, v230, v103, v104
    v_max3_f32 v230, v230, v105, v106
    v_max3_f32 v230, v230, v107, v116
    v_max3_f32 v230, v230, v117, v118
    v_max_f32 v230, v230, v119
    v_mov_b32 v232, v230
    v_mov_b32 v233, v231
    s_nop 0
    v_permlane16_swap_b32 v230, v232
    v_permlane16_swap_b32 v231, v233
    v_max_f32 v230, v230, v232
    v_max_f32 v231, v231, v233
    v_mov_b32 v232, v230
    v_mov_b32 v233, v231
    s_nop 0
    v_permlane32_swap_b32 v230, v232
    v_permlane32_swap_b32 v231, v233
    v_max_f32 v230, v230, v232
    v_max_f32 v231, v231, v233
    v_sub_f32 v116, v116, v230
    v_sub_f32 v117, v117, v230
    v_sub_f32 v118, v118, v230
    v_sub_f32 v119, v119, v230
    v_exp_f32 v116, v116
    v_exp_f32 v117, v117
    v_exp_f32 v118, v118
    v_exp_f32 v119, v119
    v_sub_f32 v132, 0, v230
    v_sub_f32 v133, 0, v230
    v_sub_f32 v134, 0, v230
    v_sub_f32 v135, 0, v230
    v_cvt_pk_bf16_f32 v204, v116, v117
    v_cvt_pk_bf16_f32 v205, v118, v119
    v_sub_f32 v136, 0, v231
    v_sub_f32 v137, 0, v231
    v_sub_f32 v138, 0, v231
    v_sub_f32 v139, 0, v231
    s_waitcnt lgkmcnt(0)
    s_barrier
    ds_read_b128 v[36:39], v227 offset:0
    ds_read_b128 v[40:43], v227 offset:4352
    v_mfma_f32_16x16x16_bf16 v[212:215], v[220:221], v[204:205], 0
    ds_read_b128 v[44:47], v227 offset:64
    v_mfma_f32_16x16x16_bf16 v[140:143], v[68:69], v[204:205], 0
    v_sub_f32 v100, v100, v230
    v_sub_f32 v101, v101, v230
    ds_read_b128 v[48:51], v227 offset:4416
    v_mfma_f32_16x16x16_bf16 v[144:147], v[72:73], v[204:205], 0
    v_sub_f32 v102, v102, v230
    v_sub_f32 v103, v103, v230
    ds_read_b128 v[52:55], v227 offset:128
    v_mfma_f32_16x16x16_bf16 v[148:151], v[76:77], v[204:205], 0
    v_sub_f32 v104, v104, v230
    v_sub_f32 v105, v105, v230
    ds_read_b128 v[56:59], v227 offset:4480
    v_mfma_f32_16x16x16_bf16 v[152:155], v[80:81], v[204:205], 0
    v_sub_f32 v106, v106, v230
    v_sub_f32 v107, v107, v230
    ds_read_b128 v[60:63], v227 offset:192
    v_mfma_f32_16x16x16_bf16 v[156:159], v[84:85], v[204:205], 0
    v_sub_f32 v108, v108, v231
    v_sub_f32 v109, v109, v231
    ds_read_b128 v[64:67], v227 offset:4544
    v_mfma_f32_16x16x16_bf16 v[160:163], v[88:89], v[204:205], 0
    v_sub_f32 v110, v110, v231
    v_sub_f32 v111, v111, v231
    v_mfma_f32_16x16x16_bf16 v[164:167], v[92:93], v[204:205], 0
    v_sub_f32 v112, v112, v231
    v_sub_f32 v113, v113, v231
    v_mfma_f32_16x16x16_bf16 v[168:171], v[96:97], v[204:205], 0
    v_sub_f32 v114, v114, v231
    v_sub_f32 v115, v115, v231
L_body0:
    s_waitcnt lgkmcnt(5)
    v_mfma_f32_16x16x32_bf16 v[116:119], v[36:39], v[4:7], v[132:135]
    v_exp_f32 v100, v100
    s_add_u32 s31, s31, 34816
    v_mfma_f32_16x16x32_bf16 v[124:127], v[36:39], v[20:23], v[136:139]
    v_exp_f32 v101, v101
    s_cmp_eq_u32 s31, 104448
    v_mfma_f32_16x16x32_bf16 v[120:123], v[40:43], v[4:7], v[132:135]
    v_exp_f32 v102, v102
    v_cvt_pk_bf16_f32 v204, v100, v101
    v_mfma_f32_16x16x32_bf16 v[128:131], v[40:43], v[20:23], v[136:139]
    v_exp_f32 v103, v103
    s_cselect_b32 s31, 0, s31
    v_mfma_f32_16x16x32_bf16 v[116:119], v[44:47], v[8:11], v[116:119]
    v_exp_f32 v104, v104
    v_cvt_pk_bf16_f32 v205, v102, v103
    v_mfma_f32_16x16x32_bf16 v[124:127], v[44:47], v[24:27], v[124:127]
    v_exp_f32 v105, v105
    v_add_u32 v227, s31, v224
    s_waitcnt lgkmcnt(0)
    v_mfma_f32_16x16x32_bf16 v[120:123], v[48:51], v[8:11], v[120:123]
    v_exp_f32 v106, v106
    v_cvt_pk_bf16_f32 v206, v104, v105
    v_mfma_f32_16x16x32_bf16 v[128:131], v[48:51], v[24:27], v[128:131]
    v_exp_f32 v107, v107
    v_add_u32 v228, s31, v225
    v_mfma_f32_16x16x32_bf16 v[116:119], v[52:55], v[12:15], v[116:119]
    v_exp_f32 v108, v108
    v_cvt_pk_bf16_f32 v207, v106, v107
    v_mfma_f32_16x16x32_bf16 v[124:127], v[52:55], v[28:31], v[124:127]
    v_exp_f32 v109, v109
    v_add_u32 v229, s31, v226
    v_mfma_f32_16x16x32_bf16 v[120:123], v[56:59], v[12:15], v[120:123]
    v_exp_f32 v110, v110
    v_cvt_pk_bf16_f32 v208, v108, v109
    v_mfma_f32_16x16x32_bf16 v[128:131], v[56:59], v[28:31], v[128:131]
    v_exp_f32 v111, v111
    v_mfma_f32_16x16x32_bf16 v[116:119], v[60:63], v[16:19], v[116:119]
    v_exp_f32 v112, v112
    v_cvt_pk_bf16_f32 v209, v110, v111
    v_mfma_f32_16x16x32_bf16 v[124:127], v[60:63], v[32:35], v[124:127]
    v_exp_f32 v113, v113
    v_mfma_f32_16x16x32_bf16 v[120:123], v[64:67], v[16:19], v[120:123]
    v_exp_f32 v114, v114
    v_cvt_pk_bf16_f32 v210, v112, v113
    v_mfma_f32_16x16x32_bf16 v[128:131], v[64:67], v[32:35], v[128:131]
    v_exp_f32 v115, v115
    s_barrier
    ds_read_b64_tr_b16 v[68:69], v228 offset:0
    ds_read_b64_tr_b16 v[70:71], v228 offset:4352
    ds_read_b64_tr_b16 v[72:73], v229 offset:0
    ds_read_b64_tr_b16 v[74:75], v229 offset:4352
    v_cvt_pk_bf16_f32 v211, v114, v115
    ds_read_b64_tr_b16 v[76:77], v228 offset:64
    ds_read_b64_tr_b16 v[78:79], v228 offset:4416
    v_mfma_f32_16x16x32_bf16 v[212:215], v[220:223], v[204:207], v[212:215]
    ds_read_b64_tr_b16 v[80:81], v229 offset:64
    ds_read_b64_tr_b16 v[82:83], v229 offset:4416
    v_mfma_f32_16x16x32_bf16 v[216:219], v[220:223], v[208:211], v[216:219]
    ds_read_b64_tr_b16 v[84:85], v228 offset:128
    ds_read_b64_tr_b16 v[86:87], v228 offset:4480
    s_waitcnt lgkmcnt(7)
    v_mfma_f32_16x16x32_bf16 v[140:143], v[68:71], v[204:207], v[140:143]
    ds_read_b64_tr_b16 v[88:89], v229 offset:128
    v_mfma_f32_16x16x32_bf16 v[172:175], v[68:71], v[208:211], v[172:175]
    ds_read_b64_tr_b16 v[90:91], v229 offset:4480
    v_max3_f32 v230, v116, v117, v118
    s_waitcnt lgkmcnt(5)
    v_mfma_f32_16x16x32_bf16 v[144:147], v[72:75], v[204:207], v[144:147]
    ds_read_b64_tr_b16 v[92:93], v228 offset:192
    v_max3_f32 v231, v119, v120, v121
    v_mfma_f32_16x16x32_bf16 v[176:179], v[72:75], v[208:211], v[176:179]
    ds_read_b64_tr_b16 v[94:95], v228 offset:4544
    v_max3_f32 v230, v230, v122, v123
    v_mfma_f32_16x16x32_bf16 v[148:151], v[76:79], v[204:207], v[148:151]
    ds_read_b64_tr_b16 v[96:97], v229 offset:192
    v_max3_f32 v231, v231, v124, v125
    v_mfma_f32_16x16x32_bf16 v[180:183], v[76:79], v[208:211], v[180:183]
    ds_read_b64_tr_b16 v[98:99], v229 offset:4544
    v_max3_f32 v230, v230, v126, v127
    v_max3_f32 v231, v231, v128, v129
    s_waitcnt lgkmcnt(3)
    v_mfma_f32_16x16x32_bf16 v[152:155], v[80:83], v[204:207], v[152:155]
    v_max3_f32 v230, v230, v130, v131
    v_max_f32 v230, v230, v231
    v_mfma_f32_16x16x32_bf16 v[184:187], v[80:83], v[208:211], v[184:187]
    v_cmp_lt_f32 vcc, s47, v230
    v_mfma_f32_16x16x32_bf16 v[156:159], v[84:87], v[204:207], v[156:159]
    v_mfma_f32_16x16x32_bf16 v[188:191], v[84:87], v[208:211], v[188:191]
    s_waitcnt lgkmcnt(0)
    s_barrier
    ds_read_b128 v[36:39], v227 offset:0
    ds_read_b128 v[40:43], v227 offset:4352
    v_mfma_f32_16x16x32_bf16 v[160:163], v[88:91], v[204:207], v[160:163]
    ds_read_b128 v[44:47], v227 offset:64
    v_mfma_f32_16x16x32_bf16 v[192:195], v[88:91], v[208:211], v[192:195]
    ds_read_b128 v[48:51], v227 offset:4416
    v_mfma_f32_16x16x32_bf16 v[164:167], v[92:95], v[204:207], v[164:167]
    ds_read_b128 v[52:55], v227 offset:128
    v_mfma_f32_16x16x32_bf16 v[196:199], v[92:95], v[208:211], v[196:199]
    ds_read_b128 v[56:59], v227 offset:4480
    v_mfma_f32_16x16x32_bf16 v[168:171], v[96:99], v[204:207], v[168:171]
    ds_read_b128 v[60:63], v227 offset:192
    v_mfma_f32_16x16x32_bf16 v[200:203], v[96:99], v[208:211], v[200:203]
    ds_read_b128 v[64:67], v227 offset:4544
    s_cbranch_vccnz L_rare0
L_back0:
L_body1:
    s_waitcnt lgkmcnt(5)
    v_mfma_f32_16x16x32_bf16 v[100:103], v[36:39], v[4:7], v[132:135]
    v_exp_f32 v116, v116
    s_add_u32 s31, s31, 34816
    v_mfma_f32_16x16x32_bf16 v[108:111], v[36:39], v[20:23], v[136:139]
    v_exp_f32 v117, v117
    s_cmp_eq_u32 s31, 104448
    v_mfma_f32_16x16x32_bf16 v[104:107], v[40:43], v[4:7], v[132:135]
    v_exp_f32 v118, v118
    v_cvt_pk_bf16_f32 v204, v116, v117
    v_mfma_f32_16x16x32_bf16 v[112:115], v[40:43], v[20:23], v[136:139]
    v_exp_f32 v119, v119
    s_cselect_b32 s31, 0, s31
    v_mfma_f32_16x16x32_bf16 v[100:103], v[44:47], v[8:11], v[100:103]
    v_exp_f32 v120, v120
    v_cvt_pk_bf16_f32 v205, v118, v119
    v_mfma_f32_16x16x32_bf16 v[108:111], v[44:47], v[24:27], v[108:111]
    v_exp_f32 v121, v121
    v_add_u32 v227, s31, v224
    s_waitcnt lgkmcnt(0)
    v_mfma_f32_16x16x32_bf16 v[104:107], v[48:51], v[8:11], v[104:107]
    v_exp_f32 v122, v122
    v_cvt_pk_bf16_f32 v206, v120, v121
    v_mfma_f32_16x16x32_bf16 v[112:115], v[48:51], v[24:27], v[112:115]
    v_exp_f32 v123, v123
    v_add_u32 v228, s31, v225
    v_mfma_f32_16x16x32_bf16 v[100:103], v[52:55], v[12:15], v[100:103]
    v_exp_f32 v124, v124
    v_cvt_pk_bf16_f32 v207, v122, v123
    v_mfma_f32_16x16x32_bf16 v[108:111], v[52:55], v[28:31], v[108:111]
    v_exp_f32 v125, v125
    v_add_u32 v229, s31, v226
    v_mfma_f32_16x16x32_bf16 v[104:107], v[56:59], v[12:15], v[104:107]
    v_exp_f32 v126, v126
    v_cvt_pk_bf16_f32 v208, v124, v125
    v_mfma_f32_16x16x32_bf16 v[112:115], v[56:59], v[28:31], v[112:115]
    v_exp_f32 v127, v127
    v_mfma_f32_16x16x32_bf16 v[100:103], v[60:63], v[16:19], v[100:103]
    v_exp_f32 v128, v128
    v_cvt_pk_bf16_f32 v209, v126, v127
    v_mfma_f32_16x16x32_bf16 v[108:111], v[60:63], v[32:35], v[108:111]
    v_exp_f32 v129, v129
    v_mfma_f32_16x16x32_bf16 v[104:107], v[64:67], v[16:19], v[104:107]
    v_exp_f32 v130, v130
    v_cvt_pk_bf16_f32 v210, v128, v129
    v_mfma_f32_16x16x32_bf16 v[112:115], v[64:67], v[32:35], v[112:115]
    v_exp_f32 v131, v131
    s_barrier
    ds_read_b64_tr_b16 v[68:69], v228 offset:0
    ds_read_b64_tr_b16 v[70:71], v228 offset:4352
    ds_read_b64_tr_b16 v[72:73], v229 offset:0
    ds_read_b64_tr_b16 v[74:75], v229 offset:4352
    v_cvt_pk_bf16_f32 v211, v130, v131
    ds_read_b64_tr_b16 v[76:77], v228 offset:64
    ds_read_b64_tr_b16 v[78:79], v228 offset:4416
    v_mfma_f32_16x16x32_bf16 v[212:215], v[220:223], v[204:207], v[212:215]
    ds_read_b64_tr_b16 v[80:81], v229 offset:64
    ds_read_b64_tr_b16 v[82:83], v229 offset:4416
    v_mfma_f32_16x16x32_bf16 v[216:219], v[220:223], v[208:211], v[216:219]
    ds_read_b64_tr_b16 v[84:85], v228 offset:128
    ds_read_b64_tr_b16 v[86:87], v228 offset:4480
    s_waitcnt lgkmcnt(7)
    v_mfma_f32_16x16x32_bf16 v[140:143], v[68:71], v[204:207], v[140:143]
    ds_read_b64_tr_b16 v[88:89], v229 offset:128
    v_mfma_f32_16x16x32_bf16 v[172:175], v[68:71], v[208:211], v[172:175]
    ds_read_b64_tr_b16 v[90:91], v229 offset:4480
    v_max3_f32 v230, v100, v101, v102
    s_waitcnt lgkmcnt(5)
    v_mfma_f32_16x16x32_bf16 v[144:147], v[72:75], v[204:207], v[144:147]
    ds_read_b64_tr_b16 v[92:93], v228 offset:192
    v_max3_f32 v231, v103, v104, v105
    v_mfma_f32_16x16x32_bf16 v[176:179], v[72:75], v[208:211], v[176:179]
    ds_read_b64_tr_b16 v[94:95], v228 offset:4544
    v_max3_f32 v230, v230, v106, v107
    v_mfma_f32_16x16x32_bf16 v[148:151], v[76:79], v[204:207], v[148:151]
    ds_read_b64_tr_b16 v[96:97], v229 offset:192
    v_max3_f32 v231, v231, v108, v109
    v_mfma_f32_16x16x32_bf16 v[180:183], v[76:79], v[208:211], v[180:183]
    ds_read_b64_tr_b16 v[98:99], v229 offset:4544
    v_max3_f32 v230, v230, v110, v111
    v_max3_f32 v231, v231, v112, v113
    s_waitcnt lgkmcnt(3)
    v_mfma_f32_16x16x32_bf16 v[152:155], v[80:83], v[204:207], v[152:155]
    v_max3_f32 v230, v230, v114, v115
    v_max_f32 v230, v230, v231
    v_mfma_f32_16x16x32_bf16 v[184:187], v[80:83], v[208:211], v[184:187]
    v_cmp_lt_f32 vcc, s47, v230
    s_add_u32 s30, s30, 1
    v_mfma_f32_16x16x32_bf16 v[156:159], v[84:87], v[204:207], v[156:159]
    s_cmp_lt_u32 s30, 15
    v_mfma_f32_16x16x32_bf16 v[188:191], v[84:87], v[208:211], v[188:191]
    s_waitcnt lgkmcnt(0)
    s_barrier
    ds_read_b128 v[36:39], v227 offset:0
    ds_read_b128 v[40:43], v227 offset:4352
    v_mfma_f32_16x16x32_bf16 v[160:163], v[88:91], v[204:207], v[160:163]
    ds_read_b128 v[44:47], v227 offset:64
    v_mfma_f32_16x16x32_bf16 v[192:195], v[88:91], v[208:211], v[192:195]
    ds_read_b128 v[48:51], v227 offset:4416
    v_mfma_f32_16x16x32_bf16 v[164:167], v[92:95], v[204:207], v[164:167]
    ds_read_b128 v[52:55], v227 offset:128
    v_mfma_f32_16x16x32_bf16 v[196:199], v[92:95], v[208:211], v[196:199]
    ds_read_b128 v[56:59], v227 offset:4480
    v_mfma_f32_16x16x32_bf16 v[168:171], v[96:99], v[204:207], v[168:171]
    ds_read_b128 v[60:63], v227 offset:192
    v_mfma_f32_16x16x32_bf16 v[200:203], v[96:99], v[208:211], v[200:203]
    ds_read_b128 v[64:67], v227 offset:4544
    s_cbranch_vccnz L_rare1
L_back1:
    s_cbranch_scc1 L_body0
L_tail:
    s_waitcnt lgkmcnt(5)
    v_mfma_f32_16x16x32_bf16 v[116:119], v[36:39], v[4:7], v[132:135]
    v_exp_f32 v100, v100
    v_mfma_f32_16x16x32_bf16 v[124:127], v[36:39], v[20:23], v[136:139]
    v_exp_f32 v101, v101
    v_mfma_f32_16x16x32_bf16 v[120:123], v[40:43], v[4:7], v[132:135]
    v_exp_f32 v102, v102
    v_cvt_pk_bf16_f32 v204, v100, v101
    v_mfma_f32_16x16x32_bf16 v[128:131], v[40:43], v[20:23], v[136:139]
    v_exp_f32 v103, v103
    v_mfma_f32_16x16x32_bf16 v[116:119], v[44:47], v[8:11], v[116:119]
    v_exp_f32 v104, v104
    v_cvt_pk_bf16_f32 v205, v102, v103
    v_mfma_f32_16x16x32_bf16 v[124:127], v[44:47], v[24:27], v[124:127]
    v_exp_f32 v105, v105
    s_waitcnt lgkmcnt(0)
    v_mfma_f32_16x16x32_bf16 v[120:123], v[48:51], v[8:11], v[120:123]
    v_exp_f32 v106, v106
    v_cvt_pk_bf16_f32 v206, v104, v105
    v_mfma_f32_16x16x32_bf16 v[128:131], v[48:51], v[24:27], v[128:131]
    v_exp_f32 v107, v107
    v_mfma_f32_16x16x32_bf16 v[116:119], v[52:55], v[12:15], v[116:119]
    v_exp_f32 v108, v108
    v_cvt_pk_bf16_f32 v207, v106, v107
    v_mfma_f32_16x16x32_bf16 v[124:127], v[52:55], v[28:31], v[124:127]
    v_exp_f32 v109, v109
    v_mfma_f32_16x16x32_bf16 v[120:123], v[56:59], v[12:15], v[120:123]
    v_exp_f32 v110, v110
    v_cvt_pk_bf16_f32 v208, v108, v109
    v_mfma_f32_16x16x32_bf16 v[128:131], v[56:59], v[28:31], v[128:131]
    v_exp_f32 v111, v111
    v_mfma_f32_16x16x32_bf16 v[116:119], v[60:63], v[16:19], v[116:119]
    v_exp_f32 v112, v112
    v_cvt_pk_bf16_f32 v209, v110, v111
    v_mfma_f32_16x16x32_bf16 v[124:127], v[60:63], v[32:35], v[124:127]
    v_exp_f32 v113, v113
    v_mfma_f32_16x16x32_bf16 v[120:123], v[64:67], v[16:19], v[120:123]
    v_exp_f32 v114, v114
    v_cvt_pk_bf16_f32 v210, v112, v113
    v_mfma_f32_16x16x32_bf16 v[128:131], v[64:67], v[32:35], v[128:131]
    v_exp_f32 v115, v115
    v_mov_b32 v228, v225
    v_cvt_pk_bf16_f32 v211, v114, v115
    v_mov_b32 v229, v226
    v_add_u32 v234, -17408, v225
    v_add_u32 v235, -17408, v226
    v_max3_f32 v230, v116, v117, v118
    v_max3_f32 v231, v119, v124, v125
    v_max3_f32 v230, v230, v126, v127
    v_max3_f32 v231, v231, v120, v121
    v_max3_f32 v230, v230, v122, v123
    v_max3_f32 v231, v231, v128, v129
    v_max3_f32 v230, v230, v130, v131
    v_max_f32 v230, v230, v231
    v_cmp_lt_f32 vcc, s47, v230
    s_cbranch_vccnz L_rare2
L_back2:
    v_mfma_f32_16x16x32_bf16 v[212:215], v[220:223], v[204:207], v[212:215]
    v_exp_f32 v124, v124
    v_mfma_f32_16x16x32_bf16 v[216:219], v[220:223], v[208:211], v[216:219]
    v_exp_f32 v125, v125
    v_exp_f32 v126, v126
    s_barrier
    ds_read_b64_tr_b16 v[68:69], v228 offset:0
    ds_read_b64_tr_b16 v[70:71], v228 offset:4352
    v_cvt_pk_bf16_f32 v8, v124, v125
    ds_read_b64_tr_b16 v[72:73], v229 offset:0
    ds_read_b64_tr_b16 v[74:75], v229 offset:4352
    v_exp_f32 v127, v127
    ds_read_b64_tr_b16 v[76:77], v228 offset:64
    ds_read_b64_tr_b16 v[78:79], v228 offset:4416
    v_exp_f32 v128, v128
    ds_read_b64_tr_b16 v[80:81], v229 offset:64
    ds_read_b64_tr_b16 v[82:83], v229 offset:4416
    v_cvt_pk_bf16_f32 v9, v126, v127
    s_waitcnt lgkmcnt(5)
    v_mfma_f32_16x16x32_bf16 v[140:143], v[68:71], v[204:207], v[140:143]
    ds_read_b64_tr_b16 v[84:85], v228 offset:128
    v_exp_f32 v129, v129
    v_mfma_f32_16x16x32_bf16 v[172:175], v[68:71], v[208:211], v[172:175]
    ds_read_b64_tr_b16 v[86:87], v228 offset:4480
    v_exp_f32 v130, v130
    s_waitcnt lgkmcnt(2)
    v_mfma_f32_16x16x32_bf16 v[144:147], v[72:75], v[204:207], v[144:147]
    ds_read_b64_tr_b16 v[88:89], v229 offset:128
    v_cvt_pk_bf16_f32 v10, v128, v129
    v_mfma_f32_16x16x32_bf16 v[176:179], v[72:75], v[208:211], v[176:179]
    ds_read_b64_tr_b16 v[90:91], v229 offset:4480
    v_exp_f32 v131, v131
    v_mfma_f32_16x16x32_bf16 v[148:151], v[76:79], v[204:207], v[148:151]
    ds_read_b64_tr_b16 v[92:93], v228 offset:192
    v_exp_f32 v116, v116
    v_mfma_f32_16x16x32_bf16 v[180:183], v[76:79], v[208:211], v[180:183]
    ds_read_b64_tr_b16 v[94:95], v228 offset:4544
    v_cvt_pk_bf16_f32 v11, v130, v131
    v_mfma_f32_16x16x32_bf16 v[152:155], v[80:83], v[204:207], v[152:155]
    ds_read_b64_tr_b16 v[96:97], v229 offset:192
    v_exp_f32 v117, v117
    v_mfma_f32_16x16x32_bf16 v[184:187], v[80:83], v[208:211], v[184:187]
    ds_read_b64_tr_b16 v[98:99], v229 offset:4544
    v_exp_f32 v118, v118
    v_mfma_f32_16x16x32_bf16 v[216:219], v[220:223], v[8:11], v[216:219]
    v_mov_b32 v232, v136
    s_waitcnt lgkmcnt(2)
    v_mfma_f32_16x16x32_bf16 v[156:159], v[84:87], v[204:207], v[156:159]
    v_cvt_pk_bf16_f32 v4, v116, v117
    v_exp_f32 v119, v119
    v_mfma_f32_16x16x32_bf16 v[188:191], v[84:87], v[208:211], v[188:191]
    v_exp_f32 v120, v120
    v_cvt_pk_bf16_f32 v5, v118, v119
    v_mfma_f32_16x16x32_bf16 v[160:163], v[88:91], v[204:207], v[160:163]
    v_exp_f32 v121, v121
    v_mov_b32 v233, v216
    v_mfma_f32_16x16x32_bf16 v[192:195], v[88:91], v[208:211], v[192:195]
    ds_write_b64 v244, v[232:233] offset:8192
    v_mfma_f32_16x16x32_bf16 v[164:167], v[92:95], v[204:207], v[164:167]
    v_exp_f32 v122, v122
    v_cvt_pk_bf16_f32 v6, v120, v121
    v_mfma_f32_16x16x32_bf16 v[196:199], v[92:95], v[208:211], v[196:199]
    v_exp_f32 v123, v123
    s_waitcnt lgkmcnt(1)
    v_mfma_f32_16x16x32_bf16 v[168:171], v[96:99], v[204:207], v[168:171]
    v_cvt_pk_bf16_f32 v7, v122, v123
    v_mfma_f32_16x16x32_bf16 v[200:203], v[96:99], v[208:211], v[200:203]
    s_waitcnt lgkmcnt(0)
    v_mfma_f32_16x16x32_bf16 v[212:215], v[220:223], v[4:7], v[212:215]
    s_barrier
    ds_read_b64_tr_b16 v[68:69], v234 offset:0
    ds_read_b64_tr_b16 v[70:71], v234 offset:4352
    ds_read_b64_tr_b16 v[72:73], v235 offset:0
    ds_read_b64_tr_b16 v[74:75], v235 offset:4352
    ds_read_b64_tr_b16 v[76:77], v234 offset:64
    ds_read_b64_tr_b16 v[78:79], v234 offset:4416
    ds_read_b64_tr_b16 v[80:81], v235 offset:64
    ds_read_b64_tr_b16 v[82:83], v235 offset:4416
    s_waitcnt lgkmcnt(6)
    v_mfma_f32_16x16x32_bf16 v[172:175], v[68:71], v[8:11], v[172:175]
    ds_read_b64_tr_b16 v[84:85], v234 offset:128
    ds_read_b64_tr_b16 v[86:87], v234 offset:4480
    s_waitcnt lgkmcnt(6)
    v_mfma_f32_16x16x32_bf16 v[176:179], v[72:75], v[8:11], v[176:179]
    ds_read_b64_tr_b16 v[88:89], v235 offset:128
    ds_read_b64_tr_b16 v[90:91], v235 offset:4480
    s_waitcnt lgkmcnt(4)
    v_mfma_f32_16x16x32_bf16 v[180:183], v[76:79], v[8:11], v[180:183]
    ds_read_b64_tr_b16 v[92:93], v234 offset:192
    ds_read_b64_tr_b16 v[94:95], v234 offset:4544
    v_mfma_f32_16x16x32_bf16 v[140:143], v[68:71], v[4:7], v[140:143]
    ds_read_b64_tr_b16 v[96:97], v235 offset:192
    ds_read_b64_tr_b16 v[98:99], v235 offset:4544
    v_mfma_f32_16x16x32_bf16 v[184:187], v[80:83], v[8:11], v[184:187]
    ds_read_b64 v[232:233], v245 offset:8192
    ds_write_b128 v242, v[172:175] offset:0
    v_mfma_f32_16x16x32_bf16 v[144:147], v[72:75], v[4:7], v[144:147]
    s_waitcnt lgkmcnt(5)
    v_mfma_f32_16x16x32_bf16 v[188:191], v[84:87], v[8:11], v[188:191]
    ds_write_b128 v242, v[176:179] offset:1024
    v_mfma_f32_16x16x32_bf16 v[148:151], v[76:79], v[4:7], v[148:151]
    v_mfma_f32_16x16x32_bf16 v[192:195], v[88:91], v[8:11], v[192:195]
    ds_write_b128 v242, v[180:183] offset:2048
    v_mfma_f32_16x16x32_bf16 v[152:155], v[80:83], v[4:7], v[152:155]
    s_waitcnt lgkmcnt(2)
    v_mfma_f32_16x16x32_bf16 v[196:199], v[92:95], v[8:11], v[196:199]
    v_min_f32 v230, v132, v232
    v_sub_f32 v231, v230, v132
    ds_write_b128 v242, v[184:187] offset:3072
    v_mfma_f32_16x16x32_bf16 v[156:159], v[84:87], v[4:7], v[156:159]
    v_sub_f32 v232, v230, v232
    v_exp_f32 v231, v231
    v_mfma_f32_16x16x32_bf16 v[200:203], v[96:99], v[8:11], v[200:203]
    v_exp_f32 v232, v232
    s_nop 0
    ds_write_b128 v242, v[188:191] offset:4096
    v_mfma_f32_16x16x32_bf16 v[160:163], v[88:91], v[4:7], v[160:163]
    v_mul_f32 v233, v233, v232
    v_fmac_f32 v233, v212, v231
    ds_write_b128 v242, v[192:195] offset:5120
    v_mfma_f32_16x16x32_bf16 v[164:167], v[92:95], v[4:7], v[164:167]
    v_rcp_f32 v233, v233
    s_nop 0
    ds_write_b128 v242, v[196:199] offset:6144
    v_mfma_f32_16x16x32_bf16 v[168:171], v[96:99], v[4:7], v[168:171]
    v_mul_f32 v230, v231, v233
    v_mul_f32 v231, v232, v233
    ds_write_b128 v242, v[200:203] offset:7168
    s_waitcnt lgkmcnt(0)
    s_barrier
    ds_read_b128 v[36:39], v243 offset:0
    ds_read_b128 v[40:43], v243 offset:1024
    ds_read_b128 v[44:47], v243 offset:2048
    ds_read_b128 v[48:51], v243 offset:3072
    ds_read_b128 v[52:55], v243 offset:4096
    ds_read_b128 v[56:59], v243 offset:5120
    ds_read_b128 v[60:63], v243 offset:6144
    ds_read_b128 v[64:67], v243 offset:7168
    v_pk_mul_f32 v[140:141], v[140:141], v[230:231] op_sel_hi:[1,0]
    v_pk_mul_f32 v[142:143], v[142:143], v[230:231] op_sel_hi:[1,0]
    v_pk_mul_f32 v[144:145], v[144:145], v[230:231] op_sel_hi:[1,0]
    v_pk_mul_f32 v[146:147], v[146:147], v[230:231] op_sel_hi:[1,0]
    v_pk_mul_f32 v[148:149], v[148:149], v[230:231] op_sel_hi:[1,0]
    v_pk_mul_f32 v[150:151], v[150:151], v[230:231] op_sel_hi:[1,0]
    v_pk_mul_f32 v[152:153], v[152:153], v[230:231] op_sel_hi:[1,0]
    v_pk_mul_f32 v[154:155], v[154:155], v[230:231] op_sel_hi:[1,0]
    v_pk_mul_f32 v[156:157], v[156:157], v[230:231] op_sel_hi:[1,0]
    v_pk_mul_f32 v[158:159], v[158:159], v[230:231] op_sel_hi:[1,0]
    v_pk_mul_f32 v[160:161], v[160:161], v[230:231] op_sel_hi:[1,0]
    v_pk_mul_f32 v[162:163], v[162:163], v[230:231] op_sel_hi:[1,0]
    v_pk_mul_f32 v[164:165], v[164:165], v[230:231] op_sel_hi:[1,0]
    v_pk_mul_f32 v[166:167], v[166:167], v[230:231] op_sel_hi:[1,0]
    v_pk_mul_f32 v[168:169], v[168:169], v[230:231] op_sel_hi:[1,0]
    v_pk_mul_f32 v[170:171], v[170:171], v[230:231] op_sel_hi:[1,0]
    s_waitcnt lgkmcnt(0)
    v_pk_fma_f32 v[140:141], v[36:37], v[230:231], v[140:141] op_sel:[0,1,0]
    v_pk_fma_f32 v[142:143], v[38:39], v[230:231], v[142:143] op_sel:[0,1,0]
    v_pk_fma_f32 v[144:145], v[40:41], v[230:231], v[144:145] op_sel:[0,1,0]
    v_pk_fma_f32 v[146:147], v[42:43], v[230:231], v[146:147] op_sel:[0,1,0]
    v_cvt_pk_bf16_f32 v140, v140, v141
    v_cvt_pk_bf16_f32 v141, v142, v143
    ds_write_b64 v239, v[140:141] offset:0
    v_cvt_pk_bf16_f32 v144, v144, v145
    v_cvt_pk_bf16_f32 v145, v146, v147
    ds_write_b64 v239, v[144:145] offset:32
    v_pk_fma_f32 v[148:149], v[44:45], v[230:231], v[148:149] op_sel:[0,1,0]
    v_pk_fma_f32 v[150:151], v[46:47], v[230:231], v[150:151] op_sel:[0,1,0]
    v_pk_fma_f32 v[152:153], v[48:49], v[230:231], v[152:153] op_sel:[0,1,0]
    v_pk_fma_f32 v[154:155], v[50:51], v[230:231], v[154:155] op_sel:[0,1,0]
    v_cvt_pk_bf16_f32 v148, v148, v149
    v_cvt_pk_bf16_f32 v149, v150, v151
    ds_write_b64 v239, v[148:149] offset:64
    v_cvt_pk_bf16_f32 v152, v152, v153
    v_cvt_pk_bf16_f32 v153, v154, v155
    ds_write_b64 v239, v[152:153] offset:96
    ds_read_b128 v[68:71], v240 offset:0
    ds_read_b128 v[72:75], v240 offset:2176
    v_pk_fma_f32 v[156:157], v[52:53], v[230:231], v[156:157] op_sel:[0,1,0]
    v_pk_fma_f32 v[158:159], v[54:55], v[230:231], v[158:159] op_sel:[0,1,0]
    v_pk_fma_f32 v[160:161], v[56:57], v[230:231], v[160:161] op_sel:[0,1,0]
    v_pk_fma_f32 v[162:163], v[58:59], v[230:231], v[162:163] op_sel:[0,1,0]
    v_cvt_pk_bf16_f32 v156, v156, v157
    v_cvt_pk_bf16_f32 v157, v158, v159
    ds_write_b64 v239, v[156:157] offset:128
    v_cvt_pk_bf16_f32 v160, v160, v161
    v_cvt_pk_bf16_f32 v161, v162, v163
    ds_write_b64 v239, v[160:161] offset:160
    s_waitcnt lgkmcnt(2)
    buffer_store_dwordx4 v[68:71], v241, s[20:23], 0 offen offset:0 sc1
    buffer_store_dwordx4 v[72:75], v241, s[20:23], 0 offen offset:2048 sc1
    v_pk_fma_f32 v[164:165], v[60:61], v[230:231], v[164:165] op_sel:[0,1,0]
    v_pk_fma_f32 v[166:167], v[62:63], v[230:231], v[166:167] op_sel:[0,1,0]
    v_pk_fma_f32 v[168:169], v[64:65], v[230:231], v[168:169] op_sel:[0,1,0]
    v_pk_fma_f32 v[170:171], v[66:67], v[230:231], v[170:171] op_sel:[0,1,0]
    v_cvt_pk_bf16_f32 v164, v164, v165
    v_cvt_pk_bf16_f32 v165, v166, v167
    ds_write_b64 v239, v[164:165] offset:192
    v_cvt_pk_bf16_f32 v168, v168, v169
    v_cvt_pk_bf16_f32 v169, v170, v171
    ds_write_b64 v239, v[168:169] offset:224
    ds_read_b128 v[76:79], v240 offset:128
    ds_read_b128 v[80:83], v240 offset:2304
    s_waitcnt lgkmcnt(1)
    buffer_store_dwordx4 v[76:79], v241, s[20:23], 0 offen offset:128 sc1
    s_waitcnt lgkmcnt(0)
    buffer_store_dwordx4 v[80:83], v241, s[20:23], 0 offen offset:2176 sc1
L_end:
    s_endpgm
L_loader:
    s_cmp_eq_u32 s41, 0
    s_cselect_b32 s44, 0, 2048
    s_cselect_b32 s48, 0, 4352
    s_cselect_b32 s45, 2048, 0
    s_cselect_b32 s49, 4352, 0
    s_mov_b32 s46, 6144
    s_cselect_b32 s46, 4096, s46
    s_mov_b32 s50, 13056
    s_cselect_b32 s50, 8704, s50
    s_mov_b32 s47, 4096
    s_cselect_b32 s47, 6144, s47
    s_mov_b32 s51, 8704
    s_cselect_b32 s51, 13056, s51
    s_and_b32 s42, s2, 7
    s_lshl_b32 s42, s42, 2
    s_lshr_b32 s42, 0x21102220, s42
    s_and_b32 s42, s42, 15
    v_lshrrev_b32 v2, 3, v0
    v_and_b32 v2, 2, v2
    v_xor_b32 v2, v0, v2
    v_lshlrev_b32 v2, 4, v2
    v_add_u32 v15, v2, v3
    v_add_u32 v12, 4096, v15
    v_add_u32 v13, 4032, v15
    v_add_u32 v14, 2176, v15
    v_add_u32 v15, 2112, v15
    v_mul_u32_u24 v3, 768, v1
    v_add_u32 v2, v2, v3
    s_lshr_b32 s43, s40, 2
    s_lshl_b32 s43, s43, 9
    v_lshlrev_b32 v18, 4, v0
    s_mov_b32 s34, -1
    s_mov_b32 s35, 69632
    s_mov_b32 s32, 483328
    s_mov_b32 s33, 8192
    s_mov_b32 m0, 87040
    s_mov_b32 s18, 528384
    s_lshl_b32 s29, s40, 12
    s_waitcnt lgkmcnt(0)
    s_add_u32 s12, s6, s28
    s_addc_u32 s13, s7, s39
    s_add_u32 s16, s8, s28
    s_addc_u32 s17, s9, s39
    s_add_u32 s20, s24, s29
    s_addc_u32 s21, s25, 0
    s_barrier
    buffer_load_dwordx4 v2, s[20:23], 0 offen offset:0 nt lds
    s_add_u32 m0, m0, 832
    s_nop 0
    buffer_load_dwordx4 v2, s[20:23], 0 offen offset:256 nt lds
    s_add_u32 m0, m0, 832
    s_nop 0
    buffer_load_dwordx4 v2, s[20:23], 0 offen offset:512 nt lds
    s_add_u32 m0, m0, 832
    s_nop 0
    buffer_load_dwordx4 v2, s[20:23], 0 offen offset:768 nt lds
    s_mov_b32 m0, 91392
    s_add_u32 s20, s26, s43
    s_addc_u32 s21, s27, 0
    s_movk_i32 s22, 0x200
    buffer_load_dwordx4 v18, s[20:23], 0 offen lds
    s_branch L_ld_k
L_ld_last:
    s_mov_b64 s[12:13], s[16:17]
    s_mov_b32 s33, 483328
    v_mov_b32 v4, v12
    v_mov_b32 v5, v13
    v_mov_b32 v6, v14
    v_mov_b32 v7, v15
L_ld_loop:
    s_cmp_lg_u32 s34, 14
    s_cbranch_scc1 L_ld_nox
    s_waitcnt vmcnt(48)
    s_barrier
L_ld_nox:
    s_sub_u32 s39, s34, 3
    s_cmp_ge_u32 s39, 2
    s_cbranch_scc1 L_nolim0
    s_waitcnt vmcnt(26)
    s_cmp_lt_u32 s42, 1
    s_cbranch_scc1 L_nolim0
    s_waitcnt vmcnt(22)
    s_cmp_lt_u32 s42, 2
    s_cbranch_scc1 L_nolim0
    s_waitcnt vmcnt(19)
L_nolim0:
    s_add_u32 m0, s48, s31
    s_add_u32 s36, s44, s32
    buffer_load_dwordx4 v12, s[16:19], s36 offen offset:0 nt lds
    buffer_load_dwordx4 v13, s[16:19], s36 offen offset:1088 nt lds
    buffer_load_dwordx4 v14, s[16:19], s36 offen offset:2176 nt lds
    buffer_load_dwordx4 v15, s[16:19], s36 offen offset:3264 nt lds
    s_add_u32 m0, s49, s31
    s_add_u32 s36, s45, s32
    buffer_load_dwordx4 v12, s[16:19], s36 offen offset:0 nt lds
    buffer_load_dwordx4 v13, s[16:19], s36 offen offset:1088 nt lds
    buffer_load_dwordx4 v14, s[16:19], s36 offen offset:2176 nt lds
    buffer_load_dwordx4 v15, s[16:19], s36 offen offset:3264 nt lds
    s_cmp_lt_i32 s34, 1
    s_cbranch_scc1 L_ld_first0
    s_waitcnt vmcnt(40)
    s_barrier
L_ld_first0:
    s_sub_u32 s39, s34, 2
    s_cmp_ge_u32 s39, 3
    s_cbranch_scc1 L_nolim1
    s_waitcnt vmcnt(26)
    s_cmp_lt_u32 s42, 1
    s_cbranch_scc1 L_nolim1
    s_waitcnt vmcnt(22)
    s_cmp_lt_u32 s42, 2
    s_cbranch_scc1 L_nolim1
    s_waitcnt vmcnt(19)
L_nolim1:
    s_add_u32 m0, s50, s31
    s_add_u32 s36, s46, s32
    buffer_load_dwordx4 v12, s[16:19], s36 offen offset:0 nt lds
    buffer_load_dwordx4 v13, s[16:19], s36 offen offset:1088 nt lds
    buffer_load_dwordx4 v14, s[16:19], s36 offen offset:2176 nt lds
    buffer_load_dwordx4 v15, s[16:19], s36 offen offset:3264 nt lds
    s_add_u32 m0, s51, s31
    s_add_u32 s36, s47, s32
    buffer_load_dwordx4 v12, s[16:19], s36 offen offset:0 nt lds
    buffer_load_dwordx4 v13, s[16:19], s36 offen offset:1088 nt lds
    buffer_load_dwordx4 v14, s[16:19], s36 offen offset:2176 nt lds
    buffer_load_dwordx4 v15, s[16:19], s36 offen offset:3264 nt lds
L_ld_k:
    s_sub_u32 s39, s34, 2
    s_cmp_ge_u32 s39, 2
    s_cbranch_scc1 L_nolim2
    s_waitcnt vmcnt(26)
    s_cmp_lt_u32 s42, 1
    s_cbranch_scc1 L_nolim2
    s_waitcnt vmcnt(22)
    s_cmp_lt_u32 s42, 2
    s_cbranch_scc1 L_nolim2
    s_waitcnt vmcnt(19)
L_nolim2:
    s_add_u32 m0, s48, s35
    s_add_u32 s36, s44, s33
    buffer_load_dwordx4 v4, s[12:15], s36 offen offset:0 nt lds
    buffer_load_dwordx4 v5, s[12:15], s36 offen offset:1088 nt lds
    buffer_load_dwordx4 v6, s[12:15], s36 offen offset:2176 nt lds
    buffer_load_dwordx4 v7, s[12:15], s36 offen offset:3264 nt lds
    s_add_u32 m0, s49, s35
    s_add_u32 s36, s45, s33
    buffer_load_dwordx4 v4, s[12:15], s36 offen offset:0 nt lds
    buffer_load_dwordx4 v5, s[12:15], s36 offen offset:1088 nt lds
    buffer_load_dwordx4 v6, s[12:15], s36 offen offset:2176 nt lds
    buffer_load_dwordx4 v7, s[12:15], s36 offen offset:3264 nt lds
    s_cmp_lt_i32 s34, 0
    s_cbranch_scc1 L_ld_first1
    s_waitcnt vmcnt(40)
    s_barrier
L_ld_first1:
    s_sub_u32 s39, s34, 2
    s_cmp_ge_u32 s39, 2
    s_cbranch_scc1 L_nolim3
    s_waitcnt vmcnt(26)
    s_cmp_lt_u32 s42, 1
    s_cbranch_scc1 L_nolim3
    s_waitcnt vmcnt(22)
    s_cmp_lt_u32 s42, 2
    s_cbranch_scc1 L_nolim3
    s_waitcnt vmcnt(19)
L_nolim3:
    s_add_u32 m0, s50, s35
    s_add_u32 s36, s46, s33
    buffer_load_dwordx4 v4, s[12:15], s36 offen offset:0 nt lds
    buffer_load_dwordx4 v5, s[12:15], s36 offen offset:1088 nt lds
    buffer_load_dwordx4 v6, s[12:15], s36 offen offset:2176 nt lds
    buffer_load_dwordx4 v7, s[12:15], s36 offen offset:3264 nt lds
    s_add_u32 m0, s51, s35
    s_add_u32 s36, s47, s33
    buffer_load_dwordx4 v4, s[12:15], s36 offen offset:0 nt lds
    buffer_load_dwordx4 v5, s[12:15], s36 offen offset:1088 nt lds
    buffer_load_dwordx4 v6, s[12:15], s36 offen offset:2176 nt lds
    buffer_load_dwordx4 v7, s[12:15], s36 offen offset:3264 nt lds
    s_add_u32 s35, s35, 34816
    s_cmp_eq_u32 s35, 104448
    s_cselect_b32 s35, 0, s35
    s_add_u32 s31, s35, 17408
    s_sub_u32 s32, s32, 483328
    s_and_b32 s32, s32, 483328
    s_sub_u32 s33, s33, 483328
    s_and_b32 s33, s33, 483328
    s_add_u32 s34, s34, 1
    s_cmp_lt_u32 s34, 30
    s_cbranch_scc1 L_ld_loop
    s_cmp_eq_u32 s34, 30
    s_cbranch_scc1 L_ld_last
    s_waitcnt vmcnt(32)
    s_barrier
    s_waitcnt vmcnt(16)
    s_barrier
    s_waitcnt vmcnt(0)
    s_barrier
    s_endpgm
L_rare0:
    v_max3_f32 v230, v116, v117, v118
    v_max3_f32 v230, v230, v119, v120
    v_max3_f32 v230, v230, v121, v122
    v_max_f32 v230, v230, v123
    v_max3_f32 v231, v124, v125, v126
    v_max3_f32 v231, v231, v127, v128
    v_max3_f32 v231, v231, v129, v130
    v_max_f32 v231, v231, v131
    v_mov_b32 v232, v230
    v_mov_b32 v233, v231
    s_nop 0
    v_permlane16_swap_b32 v230, v232
    v_permlane16_swap_b32 v231, v233
    v_max_f32 v230, v230, v232
    v_max_f32 v231, v231, v233
    v_mov_b32 v232, v230
    v_mov_b32 v233, v231
    s_nop 0
    v_permlane32_swap_b32 v230, v232
    v_permlane32_swap_b32 v231, v233
    v_max3_f32 v230, v230, v232, 0
    v_max3_f32 v231, v231, v233, 0
    v_exp_f32 v232, -v230
    v_exp_f32 v233, -v231
    v_sub_f32 v116, v116, v230
    v_sub_f32 v117, v117, v230
    v_sub_f32 v118, v118, v230
    v_sub_f32 v119, v119, v230
    v_sub_f32 v120, v120, v230
    v_sub_f32 v121, v121, v230
    v_sub_f32 v122, v122, v230
    v_sub_f32 v123, v123, v230
    v_sub_f32 v124, v124, v231
    v_sub_f32 v125, v125, v231
    v_sub_f32 v126, v126, v231
    v_sub_f32 v127, v127, v231
    v_sub_f32 v128, v128, v231
    v_sub_f32 v129, v129, v231
    v_sub_f32 v130, v130, v231
    v_sub_f32 v131, v131, v231
    v_sub_f32 v132, v132, v230
    v_sub_f32 v133, v133, v230
    v_sub_f32 v134, v134, v230
    v_sub_f32 v135, v135, v230
    v_sub_f32 v136, v136, v231
    v_sub_f32 v137, v137, v231
    v_sub_f32 v138, v138, v231
    v_sub_f32 v139, v139, v231
    v_mul_f32 v140, v140, v232
    v_mul_f32 v141, v141, v232
    v_mul_f32 v142, v142, v232
    v_mul_f32 v143, v143, v232
    v_mul_f32 v144, v144, v232
    v_mul_f32 v145, v145, v232
    v_mul_f32 v146, v146, v232
    v_mul_f32 v147, v147, v232
    v_mul_f32 v148, v148, v232
    v_mul_f32 v149, v149, v232
    v_mul_f32 v150, v150, v232
    v_mul_f32 v151, v151, v232
    v_mul_f32 v152, v152, v232
    v_mul_f32 v153, v153, v232
    v_mul_f32 v154, v154, v232
    v_mul_f32 v155, v155, v232
    v_mul_f32 v156, v156, v232
    v_mul_f32 v157, v157, v232
    v_mul_f32 v158, v158, v232
    v_mul_f32 v159, v159, v232
    v_mul_f32 v160, v160, v232
    v_mul_f32 v161, v161, v232
    v_mul_f32 v162, v162, v232
    v_mul_f32 v163, v163, v232
    v_mul_f32 v164, v164, v232
    v_mul_f32 v165, v165, v232
    v_mul_f32 v166, v166, v232
    v_mul_f32 v167, v167, v232
    v_mul_f32 v168, v168, v232
    v_mul_f32 v169, v169, v232
    v_mul_f32 v170, v170, v232
    v_mul_f32 v171, v171, v232
    v_mul_f32 v172, v172, v233
    v_mul_f32 v173, v173, v233
    v_mul_f32 v174, v174, v233
    v_mul_f32 v175, v175, v233
    v_mul_f32 v176, v176, v233
    v_mul_f32 v177, v177, v233
    v_mul_f32 v178, v178, v233
    v_mul_f32 v179, v179, v233
    v_mul_f32 v180, v180, v233
    v_mul_f32 v181, v181, v233
    v_mul_f32 v182, v182, v233
    v_mul_f32 v183, v183, v233
    v_mul_f32 v184, v184, v233
    v_mul_f32 v185, v185, v233
    v_mul_f32 v186, v186, v233
    v_mul_f32 v187, v187, v233
    v_mul_f32 v188, v188, v233
    v_mul_f32 v189, v189, v233
    v_mul_f32 v190, v190, v233
    v_mul_f32 v191, v191, v233
    v_mul_f32 v192, v192, v233
    v_mul_f32 v193, v193, v233
    v_mul_f32 v194, v194, v233
    v_mul_f32 v195, v195, v233
    v_mul_f32 v196, v196, v233
    v_mul_f32 v197, v197, v233
    v_mul_f32 v198, v198, v233
    v_mul_f32 v199, v199, v233
    v_mul_f32 v200, v200, v233
    v_mul_f32 v201, v201, v233
    v_mul_f32 v202, v202, v233
    v_mul_f32 v203, v203, v233
    v_mul_f32 v212, v212, v232
    v_mul_f32 v216, v216, v233
    s_nop 1
    s_branch L_back0
L_rare1:
    v_max3_f32 v230, v100, v101, v102
    v_max3_f32 v230, v230, v103, v104
    v_max3_f32 v230, v230, v105, v106
    v_max_f32 v230, v230, v107
    v_max3_f32 v231, v108, v109, v110
    v_max3_f32 v231, v231, v111, v112
    v_max3_f32 v231, v231, v113, v114
    v_max_f32 v231, v231, v115
    v_mov_b32 v232, v230
    v_mov_b32 v233, v231
    s_nop 0
    v_permlane16_swap_b32 v230, v232
    v_permlane16_swap_b32 v231, v233
    v_max_f32 v230, v230, v232
    v_max_f32 v231, v231, v233
    v_mov_b32 v232, v230
    v_mov_b32 v233, v231
    s_nop 0
    v_permlane32_swap_b32 v230, v232
    v_permlane32_swap_b32 v231, v233
    v_max3_f32 v230, v230, v232, 0
    v_max3_f32 v231, v231, v233, 0
    v_exp_f32 v232, -v230
    v_exp_f32 v233, -v231
    v_sub_f32 v100, v100, v230
    v_sub_f32 v101, v101, v230
    v_sub_f32 v102, v102, v230
    v_sub_f32 v103, v103, v230
    v_sub_f32 v104, v104, v230
    v_sub_f32 v105, v105, v230
    v_sub_f32 v106, v106, v230
    v_sub_f32 v107, v107, v230
    v_sub_f32 v108, v108, v231
    v_sub_f32 v109, v109, v231
    v_sub_f32 v110, v110, v231
    v_sub_f32 v111, v111, v231
    v_sub_f32 v112, v112, v231
    v_sub_f32 v113, v113, v231
    v_sub_f32 v114, v114, v231
    v_sub_f32 v115, v115, v231
    v_sub_f32 v132, v132, v230
    v_sub_f32 v133, v133, v230
    v_sub_f32 v134, v134, v230
    v_sub_f32 v135, v135, v230
    v_sub_f32 v136, v136, v231
    v_sub_f32 v137, v137, v231
    v_sub_f32 v138, v138, v231
    v_sub_f32 v139, v139, v231
    v_mul_f32 v140, v140, v232
    v_mul_f32 v141, v141, v232
    v_mul_f32 v142, v142, v232
    v_mul_f32 v143, v143, v232
    v_mul_f32 v144, v144, v232
    v_mul_f32 v145, v145, v232
    v_mul_f32 v146, v146, v232
    v_mul_f32 v147, v147, v232
    v_mul_f32 v148, v148, v232
    v_mul_f32 v149, v149, v232
    v_mul_f32 v150, v150, v232
    v_mul_f32 v151, v151, v232
    v_mul_f32 v152, v152, v232
    v_mul_f32 v153, v153, v232
    v_mul_f32 v154, v154, v232
    v_mul_f32 v155, v155, v232
    v_mul_f32 v156, v156, v232
    v_mul_f32 v157, v157, v232
    v_mul_f32 v158, v158, v232
    v_mul_f32 v159, v159, v232
    v_mul_f32 v160, v160, v232
    v_mul_f32 v161, v161, v232
    v_mul_f32 v162, v162, v232
    v_mul_f32 v163, v163, v232
    v_mul_f32 v164, v164, v232
    v_mul_f32 v165, v165, v232
    v_mul_f32 v166, v166, v232
    v_mul_f32 v167, v167, v232
    v_mul_f32 v168, v168, v232
    v_mul_f32 v169, v169, v232
    v_mul_f32 v170, v170, v232
    v_mul_f32 v171, v171, v232
    v_mul_f32 v172, v172, v233
    v_mul_f32 v173, v173, v233
    v_mul_f32 v174, v174, v233
    v_mul_f32 v175, v175, v233
    v_mul_f32 v176, v176, v233
    v_mul_f32 v177, v177, v233
    v_mul_f32 v178, v178, v233
    v_mul_f32 v179, v179, v233
    v_mul_f32 v180, v180, v233
    v_mul_f32 v181, v181, v233
    v_mul_f32 v182, v182, v233
    v_mul_f32 v183, v183, v233
    v_mul_f32 v184, v184, v233
    v_mul_f32 v185, v185, v233
    v_mul_f32 v186, v186, v233
    v_mul_f32 v187, v187, v233
    v_mul_f32 v188, v188, v233
    v_mul_f32 v189, v189, v233
    v_mul_f32 v190, v190, v233
    v_mul_f32 v191, v191, v233
    v_mul_f32 v192, v192, v233
    v_mul_f32 v193, v193, v233
    v_mul_f32 v194, v194, v233
    v_mul_f32 v195, v195, v233
    v_mul_f32 v196, v196, v233
    v_mul_f32 v197, v197, v233
    v_mul_f32 v198, v198, v233
    v_mul_f32 v199, v199, v233
    v_mul_f32 v200, v200, v233
    v_mul_f32 v201, v201, v233
    v_mul_f32 v202, v202, v233
    v_mul_f32 v203, v203, v233
    v_mul_f32 v212, v212, v232
    v_mul_f32 v216, v216, v233
    s_nop 1
    s_branch L_back1
L_rare2:
    v_max3_f32 v230, v116, v117, v118
    v_max3_f32 v230, v230, v119, v120
    v_max3_f32 v230, v230, v121, v122
    v_max_f32 v230, v230, v123
    v_max3_f32 v231, v124, v125, v126
    v_max3_f32 v231, v231, v127, v128
    v_max3_f32 v231, v231, v129, v130
    v_max_f32 v231, v231, v131
    v_mov_b32 v232, v230
    v_mov_b32 v233, v231
    s_nop 0
    v_permlane16_swap_b32 v230, v232
    v_permlane16_swap_b32 v231, v233
    v_max_f32 v230, v230, v232
    v_max_f32 v231, v231, v233
    v_mov_b32 v232, v230
    v_mov_b32 v233, v231
    s_nop 0
    v_permlane32_swap_b32 v230, v232
    v_permlane32_swap_b32 v231, v233
    v_max3_f32 v230, v230, v232, 0
    v_max3_f32 v231, v231, v233, 0
    v_exp_f32 v232, -v230
    v_exp_f32 v233, -v231
    v_sub_f32 v116, v116, v230
    v_sub_f32 v117, v117, v230
    v_sub_f32 v118, v118, v230
    v_sub_f32 v119, v119, v230
    v_sub_f32 v120, v120, v230
    v_sub_f32 v121, v121, v230
    v_sub_f32 v122, v122, v230
    v_sub_f32 v123, v123, v230
    v_sub_f32 v124, v124, v231
    v_sub_f32 v125, v125, v231
    v_sub_f32 v126, v126, v231
    v_sub_f32 v127, v127, v231
    v_sub_f32 v128, v128, v231
    v_sub_f32 v129, v129, v231
    v_sub_f32 v130, v130, v231
    v_sub_f32 v131, v131, v231
    v_sub_f32 v132, v132, v230
    v_sub_f32 v133, v133, v230
    v_sub_f32 v134, v134, v230
    v_sub_f32 v135, v135, v230
    v_sub_f32 v136, v136, v231
    v_sub_f32 v137, v137, v231
    v_sub_f32 v138, v138, v231
    v_sub_f32 v139, v139, v231
    v_mul_f32 v140, v140, v232
    v_mul_f32 v141, v141, v232
    v_mul_f32 v142, v142, v232
    v_mul_f32 v143, v143, v232
    v_mul_f32 v144, v144, v232
    v_mul_f32 v145, v145, v232
    v_mul_f32 v146, v146, v232
    v_mul_f32 v147, v147, v232
    v_mul_f32 v148, v148, v232
    v_mul_f32 v149, v149, v232
    v_mul_f32 v150, v150, v232
    v_mul_f32 v151, v151, v232
    v_mul_f32 v152, v152, v232
    v_mul_f32 v153, v153, v232
    v_mul_f32 v154, v154, v232
    v_mul_f32 v155, v155, v232
    v_mul_f32 v156, v156, v232
    v_mul_f32 v157, v157, v232
    v_mul_f32 v158, v158, v232
    v_mul_f32 v159, v159, v232
    v_mul_f32 v160, v160, v232
    v_mul_f32 v161, v161, v232
    v_mul_f32 v162, v162, v232
    v_mul_f32 v163, v163, v232
    v_mul_f32 v164, v164, v232
    v_mul_f32 v165, v165, v232
    v_mul_f32 v166, v166, v232
    v_mul_f32 v167, v167, v232
    v_mul_f32 v168, v168, v232
    v_mul_f32 v169, v169, v232
    v_mul_f32 v170, v170, v232
    v_mul_f32 v171, v171, v232
    v_mul_f32 v172, v172, v233
    v_mul_f32 v173, v173, v233
    v_mul_f32 v174, v174, v233
    v_mul_f32 v175, v175, v233
    v_mul_f32 v176, v176, v233
    v_mul_f32 v177, v177, v233
    v_mul_f32 v178, v178, v233
    v_mul_f32 v179, v179, v233
    v_mul_f32 v180, v180, v233
    v_mul_f32 v181, v181, v233
    v_mul_f32 v182, v182, v233
    v_mul_f32 v183, v183, v233
    v_mul_f32 v184, v184, v233
    v_mul_f32 v185, v185, v233
    v_mul_f32 v186, v186, v233
    v_mul_f32 v187, v187, v233
    v_mul_f32 v188, v188, v233
    v_mul_f32 v189, v189, v233
    v_mul_f32 v190, v190, v233
    v_mul_f32 v191, v191, v233
    v_mul_f32 v192, v192, v233
    v_mul_f32 v193, v193, v233
    v_mul_f32 v194, v194, v233
    v_mul_f32 v195, v195, v233
    v_mul_f32 v196, v196, v233
    v_mul_f32 v197, v197, v233
    v_mul_f32 v198, v198, v233
    v_mul_f32 v199, v199, v233
    v_mul_f32 v200, v200, v233
    v_mul_f32 v201, v201, v233
    v_mul_f32 v202, v202, v233
    v_mul_f32 v203, v203, v233
    v_mul_f32 v212, v212, v232
    v_mul_f32 v216, v216, v233
    v_mul_f32 v100, v100, v232
    v_mul_f32 v101, v101, v232
    v_mul_f32 v102, v102, v232
    v_mul_f32 v103, v103, v232
    v_mul_f32 v104, v104, v232
    v_mul_f32 v105, v105, v232
    v_mul_f32 v106, v106, v232
    v_mul_f32 v107, v107, v232
    v_mul_f32 v108, v108, v233
    v_mul_f32 v109, v109, v233
    v_mul_f32 v110, v110, v233
    v_mul_f32 v111, v111, v233
    v_mul_f32 v112, v112, v233
    v_mul_f32 v113, v113, v233
    v_mul_f32 v114, v114, v233
    v_mul_f32 v115, v115, v233
    v_cvt_pk_bf16_f32 v204, v100, v101
    v_cvt_pk_bf16_f32 v205, v102, v103
    v_cvt_pk_bf16_f32 v206, v104, v105
    v_cvt_pk_bf16_f32 v207, v106, v107
    v_cvt_pk_bf16_f32 v208, v108, v109
    v_cvt_pk_bf16_f32 v209, v110, v111
    v_cvt_pk_bf16_f32 v210, v112, v113
    v_cvt_pk_bf16_f32 v211, v114, v115
    s_nop 1
    s_branch L_back2
.section .rodata,"a"
.p2align 6
.amdhsa_kernel standalone__tree_speculative_verify_tree_attention_over_candidate_token_tree__sampling_kernel
  .amdhsa_next_free_vgpr 248
  .amdhsa_next_free_sgpr 56
  .amdhsa_accum_offset 248
  .amdhsa_group_segment_fixed_size 0
  .amdhsa_kernarg_size 72
  .amdhsa_user_sgpr_count 2
  .amdhsa_user_sgpr_kernarg_segment_ptr 1
  .amdhsa_system_sgpr_workgroup_id_x 1
.end_amdhsa_kernel
```
